```python
import torch

def _softmax(x, axis=-1):
    return torch.softmax(x, dim=axis)

def _gelu(x):
    return torch.nn.functional.gelu(x, approximate='tanh')

def _silu(x):
    return torch.nn.functional.silu(x)

def _sigmoid(x):
    return torch.sigmoid(x)

def _layernorm(x, axis=-1, eps=1e-05):
    m = x.mean(dim=axis, keepdim=True)
    v = x.var(dim=axis, keepdim=True, unbiased=False)
    return (x - m) / torch.sqrt(v + eps)

def _scatter_add(tgt, idx, src, axis=0):
    return tgt.clone().index_add_(axis, idx, src)

def _segment_sum(src, seg, n):
    out = torch.zeros((n,) + src.shape[1:], dtype=src.dtype)
    return out.index_add_(0, seg, src)

def _pad(x, pw):
    flat = tuple((v for pair in reversed(pw) for v in pair))
    return torch.nn.functional.pad(x, flat)
kernel_name = 'standalone__tree_speculative_verify_tree_attention_over_candidate_token_tree__decode'

def setup_inputs():

    _w = lambda a: (lambda t: t.to(torch.bfloat16) if t.is_floating_point() else t)(torch.as_tensor(a))
    B, Hq, Hkv, T, C, D = (1, 32, 32, 1, 8192, 128)
    tree_mask = torch.zeros((B, T, T), dtype=float)
    for b in range(B):
        parent = torch.zeros(T, dtype=torch.int64)
        for i in range(1, T):
            parent[i] = int(torch.randint(0, i, (1,)).item())
        for i in range(T):
            j = i
            tree_mask[b, i, j] = 1.0
            while j > 0:
                j = parent[j]
                tree_mask[b, i, j] = 1.0
    return {'q': _w((lambda *s: torch.randn(*s, dtype=torch.bfloat16) * 0.8)(B, Hq, T, D)), 'k_cache': _w((lambda *s: torch.randn(*s, dtype=torch.bfloat16) * 0.8)(B, Hkv, C, D)), 'v_cache': _w((lambda *s: torch.randn(*s, dtype=torch.bfloat16) * 0.05)(B, Hkv, C, D)), 'k_tree': _w((lambda *s: torch.randn(*s, dtype=torch.bfloat16) * 0.8)(B, Hkv, T, D)), 'v_tree': _w((lambda *s: torch.randn(*s, dtype=torch.bfloat16) * 0.05)(B, Hkv, T, D)), 'tree_mask': _w(tree_mask)}

def reference(q, k_cache, v_cache, k_tree, v_tree, tree_mask):
    B, Hq, T, D = q.shape
    Hkv, C = (k_cache.shape[1], k_cache.shape[2])
    rep = Hq // Hkv
    kc = (lambda x, n, axis: torch.repeat_interleave(x, n, dim=axis))(k_cache, rep, axis=1)
    vc = (lambda x, n, axis: torch.repeat_interleave(x, n, dim=axis))(v_cache, rep, axis=1)
    kt = (lambda x, n, axis: torch.repeat_interleave(x, n, dim=axis))(k_tree, rep, axis=1)
    vt = (lambda x, n, axis: torch.repeat_interleave(x, n, dim=axis))(v_tree, rep, axis=1)
    k = torch.concatenate([kc, kt], axis=2)
    v = torch.concatenate([vc, vt], axis=2)
    scale = D ** (-0.5)
    scores = torch.einsum('bhqd,bhkd->bhqk', q, k) * scale
    ctx_mask = torch.ones((B, 1, T, C), dtype=scores.dtype)
    tm = tree_mask[:, None, :, :].clone()
    full_mask = torch.concatenate([ctx_mask, tm], axis=-1)
    scores = scores + (1.0 - full_mask) * -1000000000.0
    p = _softmax(scores, axis=-1)
    return torch.einsum('bhqk,bhkd->bhqd', p, v)
```

```asm
; @launch grid=(256,1,1) block=(512,1,1) lds=8192
.amdgcn_target "amdgcn-amd-amdhsa--gfx950"
.text
.globl standalone__tree_speculative_verify_tree_attention_over_candidate_token_tree__decode_kernel
.p2align 8
.type standalone__tree_speculative_verify_tree_attention_over_candidate_token_tree__decode_kernel,@function
standalone__tree_speculative_verify_tree_attention_over_candidate_token_tree__decode_kernel:
  s_cmp_ge_u32 s2, 256
  s_cbranch_scc1 L_end
  s_load_dwordx16 s[8:23], s[0:1], 0
  s_load_dwordx2 s[24:25], s[0:1], 64
  s_memrealtime s[98:99]
  v_lshrrev_b32 v4, 6, v0
  v_and_b32 v0, 63, v0
  v_and_b32 v5, 15, v0
  v_readfirstlane_b32 s28, v4
  v_lshrrev_b32 v6, 4, v0
  v_lshlrev_b32 v6, 4, v6
  v_lshl_add_u32 v1, v5, 6, v6
  v_lshlrev_b32 v2, 4, v0
  v_lshrrev_b32 v3, 2, v5
  v_lshl_add_u32 v3, v3, 6, v6
  v_and_b32 v7, 3, v5
  v_lshl_add_u32 v7, v7, 6, v6
  s_and_b32 s26, s2, 31
  s_lshr_b32 s27, s2, 5
  s_lshl_b32 s3, s26, 21
  s_lshl_b32 s4, s27, 18
  s_or_b32 s3, s3, s4
  s_lshl_b32 s4, s26, 8
  s_lshl_b32 s68, s28, 12
  s_mov_b32 s69, s68
  s_mov_b32 s34, 0x40000
  s_mov_b32 s35, 0x00020000
  s_mov_b32 s38, 0x40000
  s_mov_b32 s39, 0x00020000
  s_movk_i32 s42, 256
  s_mov_b32 s43, 0x00020000
  s_movk_i32 s46, 256
  s_mov_b32 s47, 0x00020000
  s_waitcnt lgkmcnt(0)
  s_add_u32 s32, s10, s3
  s_addc_u32 s33, s11, 0
  s_add_u32 s40, s8, s4
  s_addc_u32 s41, s9, 0
  s_add_u32 s44, s14, s4
  s_addc_u32 s45, s15, 0
  s_add_u32 s36, s12, s3
  s_addc_u32 s37, s13, 0
  buffer_load_dwordx4 v[8:11], v3, s[40:43], 0 offen
  buffer_load_dwordx4 v[36:39], v7, s[44:47], 0 offen
  buffer_load_dwordx4 v[60:63], v1, s[32:35], s68 offen offset:0 nt
  buffer_load_dwordx4 v[64:67], v1, s[32:35], s68 offen offset:1024 nt
  buffer_load_dwordx4 v[68:71], v1, s[32:35], s68 offen offset:2048 nt
  buffer_load_dwordx4 v[72:75], v1, s[32:35], s68 offen offset:3072 nt
  s_add_u32 s68, s68, 0x8000
  buffer_load_dwordx4 v[76:79], v2, s[36:39], s69 offen offset:0 nt
  buffer_load_dwordx4 v[80:83], v2, s[36:39], s69 offen offset:1024 nt
  buffer_load_dwordx4 v[84:87], v2, s[36:39], s69 offen offset:2048 nt
  buffer_load_dwordx4 v[88:91], v2, s[36:39], s69 offen offset:3072 nt
  s_add_u32 s69, s69, 0x8000
  buffer_load_dwordx4 v[92:95], v1, s[32:35], s68 offen offset:0 nt
  buffer_load_dwordx4 v[96:99], v1, s[32:35], s68 offen offset:1024 nt
  buffer_load_dwordx4 v[100:103], v1, s[32:35], s68 offen offset:2048 nt
  buffer_load_dwordx4 v[104:107], v1, s[32:35], s68 offen offset:3072 nt
  s_add_u32 s68, s68, 0x8000
  buffer_load_dwordx4 v[108:111], v2, s[36:39], s69 offen offset:0 nt
  buffer_load_dwordx4 v[112:115], v2, s[36:39], s69 offen offset:1024 nt
  buffer_load_dwordx4 v[116:119], v2, s[36:39], s69 offen offset:2048 nt
  buffer_load_dwordx4 v[120:123], v2, s[36:39], s69 offen offset:3072 nt
  s_add_u32 s69, s69, 0x8000
  s_mov_b32 s76, 0x3e0293ee
  s_mov_b32 s77, 0x03020302
  s_mov_b32 s78, 0xff00ff00
  s_mov_b32 s79, 0xff00ff00
  s_movk_i32 s70, 4
  v_and_b32 v4, 1, v0
  v_lshlrev_b32 v4, 4, v4
  v_mov_b32 v5, 0xffff
  v_lshlrev_b32 v5, v4, v5
  v_bfe_u32 v6, v0, 1, 2
  v_cmp_eq_u32 vcc, 0, v6
  s_nop 1
  v_cndmask_b32 v32, 0, v5, vcc
  v_cmp_eq_u32 vcc, 1, v6
  s_nop 1
  v_cndmask_b32 v33, 0, v5, vcc
  v_cmp_eq_u32 vcc, 2, v6
  s_nop 1
  v_cndmask_b32 v34, 0, v5, vcc
  v_cmp_eq_u32 vcc, 3, v6
  s_nop 1
  v_cndmask_b32 v35, 0, v5, vcc
  v_mov_b32 v48, 0xff800000
  v_mov_b32 v50, 0xff800000
  v_mov_b32 v49, 0
  v_mov_b32 v51, 0
  v_mov_b32 v44, 0
  v_mov_b32 v45, 0
  v_mov_b32 v46, 0
  v_mov_b32 v47, 0
  v_and_b32 v6, 15, v0
  v_lshlrev_b32 v6, 5, v6
  v_bfe_u32 v7, v0, 4, 1
  v_lshl_add_u32 v6, v7, 4, v6
  v_lshrrev_b32 v7, 5, v0
  v_lshl_add_u32 v6, v7, 2, v6
  s_lshl_b32 s5, s28, 9
  v_add_u32 v53, s5, v6
  s_waitcnt vmcnt(16)
  v_mfma_f32_16x16x32_bf16 v[12:15], v[36:39], v[8:11], 0
  s_nop 7
  v_mov_b32_dpp v12, v13 quad_perm:[0,1,2,3] row_mask:0xf bank_mask:0x2
  v_mov_b32_dpp v12, v14 quad_perm:[0,1,2,3] row_mask:0xf bank_mask:0x4
  v_mov_b32_dpp v12, v15 quad_perm:[0,1,2,3] row_mask:0xf bank_mask:0x8
  s_nop 1
  v_add_f32_dpp v12, v12, v12 row_ror:8 row_mask:0xf bank_mask:0xf
  s_nop 1
  v_add_f32_dpp v4, v12, v12 row_ror:4 row_mask:0xf bank_mask:0xf
  s_nop 0
  v_readfirstlane_b32 s80, v4
.p2align 6
L_loop:
  s_waitcnt vmcnt(12)
  v_mfma_f32_16x16x32_bf16 v[12:15], v[60:63], v[8:11], 0
  v_mfma_f32_16x16x32_bf16 v[16:19], v[64:67], v[8:11], 0
  v_mfma_f32_16x16x32_bf16 v[20:23], v[68:71], v[8:11], 0
  v_mfma_f32_16x16x32_bf16 v[24:27], v[72:75], v[8:11], 0
  buffer_load_dwordx4 v[60:63], v1, s[32:35], s68 offen offset:0 nt
  buffer_load_dwordx4 v[64:67], v1, s[32:35], s68 offen offset:1024 nt
  buffer_load_dwordx4 v[68:71], v1, s[32:35], s68 offen offset:2048 nt
  buffer_load_dwordx4 v[72:75], v1, s[32:35], s68 offen offset:3072 nt
  s_add_u32 s68, s68, 0x8000
  v_mov_b32_dpp v12, v13 quad_perm:[0,1,2,3] row_mask:0xf bank_mask:0x2
  v_mov_b32_dpp v12, v14 quad_perm:[0,1,2,3] row_mask:0xf bank_mask:0x4
  v_mov_b32_dpp v12, v15 quad_perm:[0,1,2,3] row_mask:0xf bank_mask:0x8
  v_mov_b32_dpp v16, v17 quad_perm:[0,1,2,3] row_mask:0xf bank_mask:0x2
  v_mov_b32_dpp v16, v18 quad_perm:[0,1,2,3] row_mask:0xf bank_mask:0x4
  v_mov_b32_dpp v16, v19 quad_perm:[0,1,2,3] row_mask:0xf bank_mask:0x8
  v_mov_b32_dpp v20, v21 quad_perm:[0,1,2,3] row_mask:0xf bank_mask:0x2
  v_mov_b32_dpp v20, v22 quad_perm:[0,1,2,3] row_mask:0xf bank_mask:0x4
  v_mov_b32_dpp v20, v23 quad_perm:[0,1,2,3] row_mask:0xf bank_mask:0x8
  v_mov_b32_dpp v24, v25 quad_perm:[0,1,2,3] row_mask:0xf bank_mask:0x2
  v_mov_b32_dpp v24, v26 quad_perm:[0,1,2,3] row_mask:0xf bank_mask:0x4
  v_mov_b32_dpp v24, v27 quad_perm:[0,1,2,3] row_mask:0xf bank_mask:0x8
  v_add_f32_dpp v12, v12, v12 row_ror:8 row_mask:0xf bank_mask:0xf
  v_add_f32_dpp v16, v16, v16 row_ror:8 row_mask:0xf bank_mask:0xf
  v_add_f32_dpp v20, v20, v20 row_ror:8 row_mask:0xf bank_mask:0xf
  v_add_f32_dpp v24, v24, v24 row_ror:8 row_mask:0xf bank_mask:0xf
  v_add_f32_dpp v28, v12, v12 row_ror:4 row_mask:0xf bank_mask:0xf
  v_add_f32_dpp v29, v16, v16 row_ror:4 row_mask:0xf bank_mask:0xf
  v_add_f32_dpp v30, v20, v20 row_ror:4 row_mask:0xf bank_mask:0xf
  v_add_f32_dpp v31, v24, v24 row_ror:4 row_mask:0xf bank_mask:0xf
  v_max3_f32 v52, v28, v29, v30
  v_max_f32 v52, v52, v31
  v_cmp_gt_f32 vcc, v52, v50
  s_cbranch_vccnz L_slow0
L_fast0:
  v_fma_f32 v28, v28, s76, -v49
  v_fma_f32 v29, v29, s76, -v49
  v_fma_f32 v30, v30, s76, -v49
  v_fma_f32 v31, v31, s76, -v49
  v_exp_f32 v28, v28
  v_exp_f32 v29, v29
  v_exp_f32 v30, v30
  v_exp_f32 v31, v31
  v_and_b32 v56, 0xffff0000, v28
  v_and_b32 v57, 0xffff0000, v29
  v_and_b32 v58, 0xffff0000, v30
  v_and_b32 v59, 0xffff0000, v31
  v_add_f32 v51, v51, v28
  v_add_f32 v51, v51, v29
  v_add_f32 v51, v51, v30
  v_add_f32 v51, v51, v31
  v_sub_f32 v56, v28, v56
  v_sub_f32 v57, v29, v57
  v_sub_f32 v58, v30, v58
  v_sub_f32 v59, v31, v59
  v_cndmask_b32 v28, v28, v56, s[78:79]
  v_cndmask_b32 v29, v29, v57, s[78:79]
  v_cndmask_b32 v30, v30, v58, s[78:79]
  v_cndmask_b32 v31, v31, v59, s[78:79]
  v_perm_b32 v28, v28, v28, s77
  v_perm_b32 v29, v29, v29, s77
  v_perm_b32 v30, v30, v30, s77
  v_perm_b32 v31, v31, v31, s77
  v_and_b32 v36, v28, v32
  v_and_b32 v37, v28, v33
  v_and_b32 v38, v28, v34
  v_and_b32 v39, v28, v35
  s_waitcnt vmcnt(15)
  s_nop 0
  v_mfma_f32_16x16x32_bf16 v[44:47], v[36:39], v[76:79], v[44:47]
  v_and_b32 v40, v29, v32
  v_and_b32 v41, v29, v33
  v_and_b32 v42, v29, v34
  v_and_b32 v43, v29, v35
  s_waitcnt vmcnt(14)
  s_nop 0
  v_mfma_f32_16x16x32_bf16 v[44:47], v[40:43], v[80:83], v[44:47]
  v_and_b32 v36, v30, v32
  v_and_b32 v37, v30, v33
  v_and_b32 v38, v30, v34
  v_and_b32 v39, v30, v35
  s_waitcnt vmcnt(13)
  s_nop 0
  v_mfma_f32_16x16x32_bf16 v[44:47], v[36:39], v[84:87], v[44:47]
  v_and_b32 v40, v31, v32
  v_and_b32 v41, v31, v33
  v_and_b32 v42, v31, v34
  v_and_b32 v43, v31, v35
  s_waitcnt vmcnt(12)
  s_nop 0
  v_mfma_f32_16x16x32_bf16 v[44:47], v[40:43], v[88:91], v[44:47]
  buffer_load_dwordx4 v[76:79], v2, s[36:39], s69 offen offset:0 nt
  buffer_load_dwordx4 v[80:83], v2, s[36:39], s69 offen offset:1024 nt
  buffer_load_dwordx4 v[84:87], v2, s[36:39], s69 offen offset:2048 nt
  buffer_load_dwordx4 v[88:91], v2, s[36:39], s69 offen offset:3072 nt
  s_add_u32 s69, s69, 0x8000
  s_waitcnt vmcnt(12)
  v_mfma_f32_16x16x32_bf16 v[12:15], v[92:95], v[8:11], 0
  v_mfma_f32_16x16x32_bf16 v[16:19], v[96:99], v[8:11], 0
  v_mfma_f32_16x16x32_bf16 v[20:23], v[100:103], v[8:11], 0
  v_mfma_f32_16x16x32_bf16 v[24:27], v[104:107], v[8:11], 0
  buffer_load_dwordx4 v[92:95], v1, s[32:35], s68 offen offset:0 nt
  buffer_load_dwordx4 v[96:99], v1, s[32:35], s68 offen offset:1024 nt
  buffer_load_dwordx4 v[100:103], v1, s[32:35], s68 offen offset:2048 nt
  buffer_load_dwordx4 v[104:107], v1, s[32:35], s68 offen offset:3072 nt
  s_add_u32 s68, s68, 0x8000
  v_mov_b32_dpp v12, v13 quad_perm:[0,1,2,3] row_mask:0xf bank_mask:0x2
  v_mov_b32_dpp v12, v14 quad_perm:[0,1,2,3] row_mask:0xf bank_mask:0x4
  v_mov_b32_dpp v12, v15 quad_perm:[0,1,2,3] row_mask:0xf bank_mask:0x8
  v_mov_b32_dpp v16, v17 quad_perm:[0,1,2,3] row_mask:0xf bank_mask:0x2
  v_mov_b32_dpp v16, v18 quad_perm:[0,1,2,3] row_mask:0xf bank_mask:0x4
  v_mov_b32_dpp v16, v19 quad_perm:[0,1,2,3] row_mask:0xf bank_mask:0x8
  v_mov_b32_dpp v20, v21 quad_perm:[0,1,2,3] row_mask:0xf bank_mask:0x2
  v_mov_b32_dpp v20, v22 quad_perm:[0,1,2,3] row_mask:0xf bank_mask:0x4
  v_mov_b32_dpp v20, v23 quad_perm:[0,1,2,3] row_mask:0xf bank_mask:0x8
  v_mov_b32_dpp v24, v25 quad_perm:[0,1,2,3] row_mask:0xf bank_mask:0x2
  v_mov_b32_dpp v24, v26 quad_perm:[0,1,2,3] row_mask:0xf bank_mask:0x4
  v_mov_b32_dpp v24, v27 quad_perm:[0,1,2,3] row_mask:0xf bank_mask:0x8
  v_add_f32_dpp v12, v12, v12 row_ror:8 row_mask:0xf bank_mask:0xf
  v_add_f32_dpp v16, v16, v16 row_ror:8 row_mask:0xf bank_mask:0xf
  v_add_f32_dpp v20, v20, v20 row_ror:8 row_mask:0xf bank_mask:0xf
  v_add_f32_dpp v24, v24, v24 row_ror:8 row_mask:0xf bank_mask:0xf
  v_add_f32_dpp v28, v12, v12 row_ror:4 row_mask:0xf bank_mask:0xf
  v_add_f32_dpp v29, v16, v16 row_ror:4 row_mask:0xf bank_mask:0xf
  v_add_f32_dpp v30, v20, v20 row_ror:4 row_mask:0xf bank_mask:0xf
  v_add_f32_dpp v31, v24, v24 row_ror:4 row_mask:0xf bank_mask:0xf
  v_max3_f32 v52, v28, v29, v30
  v_max_f32 v52, v52, v31
  v_cmp_gt_f32 vcc, v52, v50
  s_cbranch_vccnz L_slow1
L_fast1:
  v_fma_f32 v28, v28, s76, -v49
  v_fma_f32 v29, v29, s76, -v49
  v_fma_f32 v30, v30, s76, -v49
  v_fma_f32 v31, v31, s76, -v49
  v_exp_f32 v28, v28
  v_exp_f32 v29, v29
  v_exp_f32 v30, v30
  v_exp_f32 v31, v31
  v_and_b32 v56, 0xffff0000, v28
  v_and_b32 v57, 0xffff0000, v29
  v_and_b32 v58, 0xffff0000, v30
  v_and_b32 v59, 0xffff0000, v31
  v_add_f32 v51, v51, v28
  v_add_f32 v51, v51, v29
  v_add_f32 v51, v51, v30
  v_add_f32 v51, v51, v31
  v_sub_f32 v56, v28, v56
  v_sub_f32 v57, v29, v57
  v_sub_f32 v58, v30, v58
  v_sub_f32 v59, v31, v59
  v_cndmask_b32 v28, v28, v56, s[78:79]
  v_cndmask_b32 v29, v29, v57, s[78:79]
  v_cndmask_b32 v30, v30, v58, s[78:79]
  v_cndmask_b32 v31, v31, v59, s[78:79]
  v_perm_b32 v28, v28, v28, s77
  v_perm_b32 v29, v29, v29, s77
  v_perm_b32 v30, v30, v30, s77
  v_perm_b32 v31, v31, v31, s77
  v_and_b32 v36, v28, v32
  v_and_b32 v37, v28, v33
  v_and_b32 v38, v28, v34
  v_and_b32 v39, v28, v35
  s_waitcnt vmcnt(15)
  s_nop 0
  v_mfma_f32_16x16x32_bf16 v[44:47], v[36:39], v[108:111], v[44:47]
  v_and_b32 v40, v29, v32
  v_and_b32 v41, v29, v33
  v_and_b32 v42, v29, v34
  v_and_b32 v43, v29, v35
  s_waitcnt vmcnt(14)
  s_nop 0
  v_mfma_f32_16x16x32_bf16 v[44:47], v[40:43], v[112:115], v[44:47]
  v_and_b32 v36, v30, v32
  v_and_b32 v37, v30, v33
  v_and_b32 v38, v30, v34
  v_and_b32 v39, v30, v35
  s_waitcnt vmcnt(13)
  s_nop 0
  v_mfma_f32_16x16x32_bf16 v[44:47], v[36:39], v[116:119], v[44:47]
  v_and_b32 v40, v31, v32
  v_and_b32 v41, v31, v33
  v_and_b32 v42, v31, v34
  v_and_b32 v43, v31, v35
  s_waitcnt vmcnt(12)
  s_nop 0
  v_mfma_f32_16x16x32_bf16 v[44:47], v[40:43], v[120:123], v[44:47]
  buffer_load_dwordx4 v[108:111], v2, s[36:39], s69 offen offset:0 nt
  buffer_load_dwordx4 v[112:115], v2, s[36:39], s69 offen offset:1024 nt
  buffer_load_dwordx4 v[116:119], v2, s[36:39], s69 offen offset:2048 nt
  buffer_load_dwordx4 v[120:123], v2, s[36:39], s69 offen offset:3072 nt
  s_add_u32 s69, s69, 0x8000
  s_sub_u32 s70, s70, 1
  s_cmp_lg_u32 s70, 0
  s_cbranch_scc1 L_loop
  v_mov_b32 v5, v51
  s_lshl_b32 s5, s28, 3
  s_add_u32 s5, s5, 4096
  v_permlane16_swap_b32 v51, v5
  v_add_f32 v51, v51, v5
  v_mov_b32 v5, v51
  v_mov_b32 v4, v49
  v_mov_b32 v6, s5
  v_permlane32_swap_b32 v51, v5
  v_add_f32 v5, v51, v5
  ds_write_b64 v6, v[4:5]
  v_permlane32_swap_b32 v44, v45
  v_permlane32_swap_b32 v46, v47
  v_add_f32 v44, v44, v45
  v_add_f32 v46, v46, v47
  ds_write2_b32 v53, v44, v46 offset0:0 offset1:2
  s_cmp_eq_u32 s28, 0
  s_cbranch_scc1 L_wave0
  s_waitcnt lgkmcnt(0)
  s_barrier
  s_endpgm
L_slow0:
  v_mov_b32 v5, v52
  s_nop 1
  v_permlane16_swap_b32 v52, v5
  v_max_f32 v52, v52, v5
  v_mov_b32 v5, v52
  s_nop 1
  v_permlane32_swap_b32 v52, v5
  v_max3_f32 v5, v52, v5, v48
  v_sub_f32 v6, v48, v5
  v_mul_f32 v6, s76, v6
  v_exp_f32 v6, v6
  v_mov_b32 v48, v5
  v_mul_f32 v49, s76, v5
  v_add_f32 v50, 0x429cd760, v5
  v_mul_f32 v51, v51, v6
  v_mul_f32 v44, v44, v6
  v_mul_f32 v45, v45, v6
  v_mul_f32 v46, v46, v6
  v_mul_f32 v47, v47, v6
  s_branch L_fast0
L_slow1:
  v_mov_b32 v5, v52
  s_nop 1
  v_permlane16_swap_b32 v52, v5
  v_max_f32 v52, v52, v5
  v_mov_b32 v5, v52
  s_nop 1
  v_permlane32_swap_b32 v52, v5
  v_max3_f32 v5, v52, v5, v48
  v_sub_f32 v6, v48, v5
  v_mul_f32 v6, s76, v6
  v_exp_f32 v6, v6
  v_mov_b32 v48, v5
  v_mul_f32 v49, s76, v5
  v_add_f32 v50, 0x429cd760, v5
  v_mul_f32 v51, v51, v6
  v_mul_f32 v44, v44, v6
  v_mul_f32 v45, v45, v6
  v_mul_f32 v46, v46, v6
  v_mul_f32 v47, v47, v6
  s_branch L_fast1
L_wave0:
  s_add_u32 s48, s16, s4
  s_addc_u32 s49, s17, 0
  s_movk_i32 s50, 256
  s_mov_b32 s51, 0x00020000
  s_mov_b32 s52, s18
  s_mov_b32 s53, s19
  s_mov_b32 s54, 2
  s_mov_b32 s55, 0x00020000
  s_mov_b32 s60, s22
  s_mov_b32 s61, s23
  s_movk_i32 s62, 256
  s_mov_b32 s63, 0x00020000
  s_or_b32 s98, s98, 1
  s_lshl_b32 s6, s26, 2
  v_mov_b32 v54, s98
  v_mov_b32 v55, 0
  v_mov_b32 v2, s6
  v_lshlrev_b32 v1, 4, v0
  v_lshlrev_b32 v3, 2, v0
  v_mov_b32 v4, 0
  s_mov_b64 exec, 1
  buffer_atomic_cmpswap v[54:55], v2, s[60:63], 0 offen offset:128 sc0
  s_mov_b64 exec, -1
  buffer_load_dword v209, v3, s[48:51], 0 offen
  buffer_load_ushort v208, v4, s[52:55], 0 offen
  s_add_u32 s56, s20, s4
  s_addc_u32 s57, s21, 0
  s_movk_i32 s58, 256
  s_mov_b32 s59, 0x00020000
  s_lshl_b32 s5, s26, 13
  s_add_u32 s64, s24, s5
  s_addc_u32 s65, s25, 0
  s_movk_i32 s66, 8192
  s_mov_b32 s67, 0x00020000
  s_add_u32 s69, s27, 1
  s_and_b32 s69, s69, 7
  s_lshl_b32 s69, s69, 10
  s_add_u32 s70, s27, 2
  s_and_b32 s70, s70, 7
  s_lshl_b32 s70, s70, 10
  s_add_u32 s71, s27, 3
  s_and_b32 s71, s71, 7
  s_lshl_b32 s71, s71, 10
  s_add_u32 s72, s27, 4
  s_and_b32 s72, s72, 7
  s_lshl_b32 s72, s72, 10
  s_add_u32 s73, s27, 5
  s_and_b32 s73, s73, 7
  s_lshl_b32 s73, s73, 10
  s_add_u32 s74, s27, 6
  s_and_b32 s74, s74, 7
  s_lshl_b32 s74, s74, 10
  s_add_u32 s75, s27, 7
  s_and_b32 s75, s75, 7
  s_lshl_b32 s75, s75, 10
  s_lshl_b32 s68, s27, 10
  s_mov_b32 s78, 0xaaaaaaaa
  s_mov_b32 s79, 0xaaaaaaaa
  s_waitcnt vmcnt(0)
  v_readfirstlane_b32 s6, v54
  v_lshlrev_b32 v208, 16, v208
  v_sub_f32 v208, 1.0, v208
  v_mul_f32 v208, 0xce6e6b28, v208
  v_mul_f32 v208, 0x3fb8aa3b, v208
  v_mov_b32 v4, s80
  v_fma_f32 v208, v4, s76, v208
  v_and_b32 v210, 0xffff0000, v209
  v_lshlrev_b32 v209, 16, v209
  s_cmp_eq_u32 s6, 0
  s_cselect_b32 s99, s98, s6
  v_mov_b32 v195, s99
  v_lshlrev_b32 v4, 3, v0
  v_mov_b32 v5, 4096
  v_mov_b32 v6, 1
  s_waitcnt lgkmcnt(0)
  s_barrier
L_tail:
  ds_read_b128 v[128:131], v5 offset:0
  ds_read_b128 v[132:135], v5 offset:16
  ds_read_b128 v[136:139], v5 offset:32
  ds_read_b128 v[140:143], v5 offset:48
  ds_read_b64 v[144:145], v4 offset:0
  ds_read_b64 v[146:147], v4 offset:512
  ds_read_b64 v[148:149], v4 offset:1024
  ds_read_b64 v[150:151], v4 offset:1536
  ds_read_b64 v[152:153], v4 offset:2048
  ds_read_b64 v[154:155], v4 offset:2560
  ds_read_b64 v[156:157], v4 offset:3072
  ds_read_b64 v[158:159], v4 offset:3584
  s_waitcnt lgkmcnt(8)
  v_max3_f32 v162, v128, v130, v132
  v_max3_f32 v162, v162, v134, v136
  v_max3_f32 v162, v162, v138, v140
  v_max_f32 v162, v162, v142
  v_sub_f32 v196, v128, v162
  v_sub_f32 v197, v130, v162
  v_sub_f32 v198, v132, v162
  v_sub_f32 v199, v134, v162
  v_sub_f32 v200, v136, v162
  v_sub_f32 v201, v138, v162
  v_sub_f32 v202, v140, v162
  v_sub_f32 v203, v142, v162
  v_exp_f32 v196, v196
  v_exp_f32 v197, v197
  v_exp_f32 v198, v198
  v_exp_f32 v199, v199
  v_exp_f32 v200, v200
  v_exp_f32 v201, v201
  v_exp_f32 v202, v202
  v_exp_f32 v203, v203
  s_waitcnt lgkmcnt(0)
  v_mul_f32 v163, v196, v129
  v_mul_f32 v160, v196, v144
  v_mul_f32 v161, v196, v145
  v_fmac_f32 v163, v197, v131
  v_fmac_f32 v160, v197, v146
  v_fmac_f32 v161, v197, v147
  v_fmac_f32 v163, v198, v133
  v_fmac_f32 v160, v198, v148
  v_fmac_f32 v161, v198, v149
  v_fmac_f32 v163, v199, v135
  v_fmac_f32 v160, v199, v150
  v_fmac_f32 v161, v199, v151
  v_fmac_f32 v163, v200, v137
  v_fmac_f32 v160, v200, v152
  v_fmac_f32 v161, v200, v153
  v_fmac_f32 v163, v201, v139
  v_fmac_f32 v160, v201, v154
  v_fmac_f32 v161, v201, v155
  v_fmac_f32 v163, v202, v141
  v_fmac_f32 v160, v202, v156
  v_fmac_f32 v161, v202, v157
  v_fmac_f32 v163, v203, v143
  v_fmac_f32 v160, v203, v158
  v_fmac_f32 v161, v203, v159
  v_mov_b32 v192, v160
  v_mov_b32 v193, v161
  v_cndmask_b32 v194, v162, v163, s[78:79]
  buffer_store_dwordx4 v[192:195], v1, s[64:67], s68 offen sc1
  s_mov_b64 exec, 1
  buffer_atomic_add v6, v2, s[60:63], 0 offen sc0
  s_mov_b64 exec, -1
  s_waitcnt vmcnt(0)
  v_readfirstlane_b32 s6, v6
  s_nop 3
  s_cmp_lg_u32 s6, 7
  s_cbranch_scc1 L_end2
L_chk:
  buffer_load_dwordx4 v[164:167], v1, s[64:67], s69 offen sc1
  buffer_load_dwordx4 v[168:171], v1, s[64:67], s70 offen sc1
  buffer_load_dwordx4 v[172:175], v1, s[64:67], s71 offen sc1
  buffer_load_dwordx4 v[176:179], v1, s[64:67], s72 offen sc1
  buffer_load_dwordx4 v[180:183], v1, s[64:67], s73 offen sc1
  buffer_load_dwordx4 v[184:187], v1, s[64:67], s74 offen sc1
  buffer_load_dwordx4 v[188:191], v1, s[64:67], s75 offen sc1
  s_waitcnt vmcnt(0)
  v_xor_b32 v196, s99, v167
  v_xor_b32 v197, s99, v171
  v_xor_b32 v198, s99, v175
  v_xor_b32 v199, s99, v179
  v_xor_b32 v200, s99, v183
  v_xor_b32 v201, s99, v187
  v_xor_b32 v202, s99, v191
  v_or3_b32 v4, v196, v197, v198
  v_or3_b32 v4, v4, v199, v200
  v_or3_b32 v4, v4, v201, v202
  v_cmp_ne_u32 vcc, 0, v4
  s_cbranch_vccnz L_chk
  v_mov_b32_dpp v167, v166 quad_perm:[1,1,3,3] row_mask:0xf bank_mask:0xf
  v_mov_b32_dpp v171, v170 quad_perm:[1,1,3,3] row_mask:0xf bank_mask:0xf
  v_mov_b32_dpp v175, v174 quad_perm:[1,1,3,3] row_mask:0xf bank_mask:0xf
  v_mov_b32_dpp v179, v178 quad_perm:[1,1,3,3] row_mask:0xf bank_mask:0xf
  v_mov_b32_dpp v183, v182 quad_perm:[1,1,3,3] row_mask:0xf bank_mask:0xf
  v_mov_b32_dpp v187, v186 quad_perm:[1,1,3,3] row_mask:0xf bank_mask:0xf
  v_mov_b32_dpp v191, v190 quad_perm:[1,1,3,3] row_mask:0xf bank_mask:0xf
  v_mov_b32_dpp v166, v166 quad_perm:[0,0,2,2] row_mask:0xf bank_mask:0xf
  v_mov_b32_dpp v170, v170 quad_perm:[0,0,2,2] row_mask:0xf bank_mask:0xf
  v_mov_b32_dpp v174, v174 quad_perm:[0,0,2,2] row_mask:0xf bank_mask:0xf
  v_mov_b32_dpp v178, v178 quad_perm:[0,0,2,2] row_mask:0xf bank_mask:0xf
  v_mov_b32_dpp v182, v182 quad_perm:[0,0,2,2] row_mask:0xf bank_mask:0xf
  v_mov_b32_dpp v186, v186 quad_perm:[0,0,2,2] row_mask:0xf bank_mask:0xf
  v_mov_b32_dpp v190, v190 quad_perm:[0,0,2,2] row_mask:0xf bank_mask:0xf
  v_max3_f32 v194, v162, v166, v170
  v_max3_f32 v194, v194, v174, v178
  v_max3_f32 v194, v194, v182, v186
  v_max3_f32 v194, v194, v190, v208
  v_sub_f32 v196, v162, v194
  v_sub_f32 v197, v166, v194
  v_sub_f32 v198, v170, v194
  v_sub_f32 v199, v174, v194
  v_sub_f32 v200, v178, v194
  v_sub_f32 v201, v182, v194
  v_sub_f32 v202, v186, v194
  v_sub_f32 v203, v190, v194
  v_sub_f32 v204, v208, v194
  v_exp_f32 v196, v196
  v_exp_f32 v197, v197
  v_exp_f32 v198, v198
  v_exp_f32 v199, v199
  v_exp_f32 v200, v200
  v_exp_f32 v201, v201
  v_exp_f32 v202, v202
  v_exp_f32 v203, v203
  v_exp_f32 v204, v204
  s_nop 0
  v_mul_f32 v195, v196, v163
  v_mul_f32 v192, v196, v160
  v_mul_f32 v193, v196, v161
  v_fmac_f32 v195, v197, v167
  v_fmac_f32 v192, v197, v164
  v_fmac_f32 v193, v197, v165
  v_fmac_f32 v195, v198, v171
  v_fmac_f32 v192, v198, v168
  v_fmac_f32 v193, v198, v169
  v_fmac_f32 v195, v199, v175
  v_fmac_f32 v192, v199, v172
  v_fmac_f32 v193, v199, v173
  v_fmac_f32 v195, v200, v179
  v_fmac_f32 v192, v200, v176
  v_fmac_f32 v193, v200, v177
  v_fmac_f32 v195, v201, v183
  v_fmac_f32 v192, v201, v180
  v_fmac_f32 v193, v201, v181
  v_fmac_f32 v195, v202, v187
  v_fmac_f32 v192, v202, v184
  v_fmac_f32 v193, v202, v185
  v_fmac_f32 v195, v203, v191
  v_fmac_f32 v192, v203, v188
  v_fmac_f32 v193, v203, v189
  v_add_f32 v195, v195, v204
  v_fmac_f32 v192, v204, v209
  v_fmac_f32 v193, v204, v210
  v_rcp_f32 v4, v195
  s_nop 0
  v_mul_f32 v192, v192, v4
  v_mul_f32 v193, v193, v4
  v_cvt_pk_bf16_f32 v4, v192, v193
  buffer_store_dword v4, v3, s[56:59], 0 offen
L_end2:
L_end:
  s_endpgm
.section .rodata,"a"
.p2align 6
.amdhsa_kernel standalone__tree_speculative_verify_tree_attention_over_candidate_token_tree__decode_kernel
  .amdhsa_next_free_vgpr 256
  .amdhsa_next_free_sgpr 100
  .amdhsa_accum_offset 256
  .amdhsa_group_segment_fixed_size 0
  .amdhsa_kernarg_size 72
  .amdhsa_user_sgpr_count 2
  .amdhsa_user_sgpr_kernarg_segment_ptr 1
  .amdhsa_system_sgpr_workgroup_id_x 1
.end_amdhsa_kernel
```
